```python
import torch

def _softmax(x, axis=-1):
    return torch.softmax(x, dim=axis)
def _gelu(x):
    return torch.nn.functional.gelu(x, approximate="tanh")
def _silu(x):
    return torch.nn.functional.silu(x)
def _sigmoid(x):
    return torch.sigmoid(x)
def _layernorm(x, axis=-1, eps=1e-5):
    m = x.mean(dim=axis, keepdim=True)
    v = x.var(dim=axis, keepdim=True, unbiased=False)
    return (x - m) / torch.sqrt(v + eps)
def _scatter_add(tgt, idx, src, axis=0):
    return tgt.clone().index_add_(axis, idx, src)
def _segment_sum(src, seg, n):
    out = torch.zeros((n,) + src.shape[1:], dtype=src.dtype)
    return out.index_add_(0, seg, src)
def _pad(x, pw):
    flat = tuple(v for pair in reversed(pw) for v in pair)
    return torch.nn.functional.pad(x, flat)

kernel_name = 'standalone__glu_gated_geglu__prompt'

def setup_inputs():

    _w = (lambda a: (lambda t: t.to(torch.bfloat16) if t.is_floating_point() else t)(torch.as_tensor(a)))
    B, S, Dm, Df = 1, 2048, 512, 1376
    return {
        "x": _w((lambda *s: torch.randn(*s, dtype=torch.bfloat16) * 0.05)(B, S, Dm)),
        "w_gate": _w((lambda *s: torch.randn(*s, dtype=torch.bfloat16) * 0.05)(Dm, Df) * (Dm ** -0.5)),
        "w_up": _w((lambda *s: torch.randn(*s, dtype=torch.bfloat16) * 0.05)(Dm, Df) * (Dm ** -0.5)),
        "w_down": _w((lambda *s: torch.randn(*s, dtype=torch.bfloat16) * 0.05)(Df, Dm) * (Df ** -0.5)),
    }

def reference(x, w_gate, w_up, w_down):
    g = torch.einsum("bsd,df->bsf", x, w_gate)
    u = torch.einsum("bsd,df->bsf", x, w_up)
    h = _gelu(g) * u
    return torch.einsum("bsf,fd->bsd", h, w_down)
```

```asm
; @launch grid=(256,1,1) block=(512,1,1) lds=163840
.amdgcn_target "amdgcn-amd-amdhsa--gfx950"
.text
.globl standalone__glu_gated_geglu__prompt_kernel
.p2align 8
.type standalone__glu_gated_geglu__prompt_kernel,@function
.set CODE_END_OFF, L_CODE_END - standalone__glu_gated_geglu__prompt_kernel - 1024
.set CODE_END_OFF2, L_CODE_END - L_COMPUTE - 64
standalone__glu_gated_geglu__prompt_kernel:
    s_cmp_ge_u32 s2, 256
    s_cbranch_scc1 L_END
    s_load_dwordx8 s[36:43], s[0:1], 0
    s_load_dwordx4 s[44:47], s[0:1], 32
    s_load_dwordx2 s[48:49], s[0:1], 48
    v_lshrrev_b32 v2, 6, v0
    v_and_b32 v1, 63, v0
    s_and_b32 s58, s2, 7
    v_readfirstlane_b32 s54, v2
    s_lshr_b32 s59, s2, 3
    s_and_b32 s50, s58, 1
    s_lshl_b32 s50, s50, 3
    s_and_b32 s57, s59, 7
    s_add_u32 s50, s50, s57
    s_lshr_b32 s61, s59, 3
    s_and_b32 s55, s54, 3
    s_cmp_ge_u32 s54, 4
    s_cbranch_scc1 L_COMPUTE
    s_lshl_b32 s60, s61, 1
    s_add_u32 s60, s60, s57
    v_lshrrev_b32 v20, 3, v1
    v_lshrrev_b32 v21, 4, v1
    v_and_b32 v22, 7, v1
    v_xor_b32 v24, v22, v21
    v_xor_b32 v23, 4, v24
    s_lshl_b32 s58, s50, 7
    s_lshl_b32 s59, s55, 5
    s_add_u32 s58, s58, s59
    s_lshl_b32 s58, s58, 10
    v_lshlrev_b32 v20, 10, v20
    v_add_u32 v25, s58, v20
    v_lshl_add_u32 v2, v24, 4, v25
    v_lshl_add_u32 v3, v23, 4, v25
    v_add_u32 v3, 8192, v3
    v_add_u32 v4, 16384, v2
    v_add_u32 v5, 16384, v3
    s_lshl_b32 s62, s55, 12
    s_and_b32 s59, s60, 7
    s_lshl_b32 s58, s59, 7
    s_mov_b32 s10, 2097152
    s_mov_b32 s11, 0x20000
    s_mov_b32 m0, s62
    s_waitcnt lgkmcnt(0)
    s_mov_b32 s8, s36
    s_and_b32 s9, s37, 0xffff
    buffer_load_dwordx4 v2, s[8:11], s58 offen lds
    s_add_u32 m0, s62, 1024
    s_nop 0
    buffer_load_dwordx4 v3, s[8:11], s58 offen lds
    s_add_u32 m0, s62, 2048
    s_nop 0
    buffer_load_dwordx4 v4, s[8:11], s58 offen lds
    s_add_u32 m0, s62, 3072
    s_nop 0
    buffer_load_dwordx4 v5, s[8:11], s58 offen lds
    s_and_b32 s58, s2, 7
    s_lshr_b32 s51, s58, 1
    s_lshl_b32 s51, s51, 2
    s_add_u32 s51, s51, s61
    s_mul_i32 s52, s51, 43
    s_add_u32 s53, s52, 43
    s_lshr_b32 s52, s52, 4
    s_lshr_b32 s53, s53, 4
    s_sub_u32 s53, s53, s52
    s_lshl_b32 s56, s58, 2
    s_add_u32 s56, s56, s61
    s_mov_b32 s98, s56
    s_mov_b32 s3, 0
    s_mul_i32 s58, s55, 44032
    s_lshl_b32 s59, s52, 6
    s_add_u32 s58, s58, s59
    s_movk_i32 s59, 2752
    v_add_u32 v26, 0, v1
    v_mul_u32_u24 v27, 171, v26
    v_lshrrev_b32 v27, 11, v27
    v_mul_u32_u24 v28, 12, v27
    v_sub_u32 v28, v26, v28
    v_lshrrev_b32 v29, 2, v27
    v_and_b32 v29, 2, v29
    v_xor_b32 v28, v28, v29
    v_mul_u32_u24 v27, s59, v27
    v_lshl_add_u32 v27, v28, 4, v27
    v_add_u32 v6, s58, v27
    v_add_u32 v26, 64, v1
    v_mul_u32_u24 v27, 171, v26
    v_lshrrev_b32 v27, 11, v27
    v_mul_u32_u24 v28, 12, v27
    v_sub_u32 v28, v26, v28
    v_lshrrev_b32 v29, 2, v27
    v_and_b32 v29, 2, v29
    v_xor_b32 v28, v28, v29
    v_mul_u32_u24 v27, s59, v27
    v_lshl_add_u32 v27, v28, 4, v27
    v_add_u32 v7, s58, v27
    v_add_u32 v26, 128, v1
    v_mul_u32_u24 v27, 171, v26
    v_lshrrev_b32 v27, 11, v27
    v_mul_u32_u24 v28, 12, v27
    v_sub_u32 v28, v26, v28
    v_lshrrev_b32 v29, 2, v27
    v_and_b32 v29, 2, v29
    v_xor_b32 v28, v28, v29
    v_mul_u32_u24 v27, s59, v27
    v_lshl_add_u32 v27, v28, 4, v27
    v_add_u32 v8, s58, v27
    s_mul_i32 s63, s55, 3072
    s_add_u32 s63, s63, 16384
    s_mov_b32 s12, s38
    s_and_b32 s13, s39, 0xffff
    s_mov_b32 s14, 1409024
    s_mov_b32 s15, 0x20000
    s_mov_b32 s16, s40
    s_and_b32 s17, s41, 0xffff
    s_mov_b32 s18, 1409024
    s_mov_b32 s19, 0x20000
    s_mov_b32 s66, 0
    s_mov_b32 s67, 0
    s_and_b32 s59, s60, 7
    s_mul_i32 s59, s59, 176128
    s_mov_b32 s65, s63
    s_branch L_LD_W
L_LD:
    s_cmp_lt_u32 s66, 2
    s_cbranch_scc1 L_LD_ISSUE
    s_waitcnt vmcnt(10)
    s_barrier
L_LD_ISSUE:
    s_add_u32 s59, s60, s66
    s_and_b32 s59, s59, 7
    s_lshl_b32 s58, s59, 7
    s_mul_i32 s59, s59, 176128
    s_add_u32 s64, s62, s67
    s_add_u32 s65, s63, s67
    s_mov_b32 m0, s64
    s_nop 0
    buffer_load_dwordx4 v2, s[8:11], s58 offen lds
    s_add_u32 m0, s64, 1024
    s_nop 0
    buffer_load_dwordx4 v3, s[8:11], s58 offen lds
    s_add_u32 m0, s64, 2048
    s_nop 0
    buffer_load_dwordx4 v4, s[8:11], s58 offen lds
    s_add_u32 m0, s64, 3072
    s_nop 0
    buffer_load_dwordx4 v5, s[8:11], s58 offen lds
L_LD_W:
    s_mov_b32 m0, s65
    s_nop 0
    buffer_load_dwordx4 v6, s[12:15], s59 offen lds
    s_add_u32 m0, s65, 1024
    s_nop 0
    buffer_load_dwordx4 v7, s[12:15], s59 offen lds
    s_add_u32 m0, s65, 2048
    s_nop 0
    buffer_load_dwordx4 v8, s[12:15], s59 offen lds
    s_add_u32 m0, s65, 12288
    s_nop 0
    buffer_load_dwordx4 v6, s[16:19], s59 offen lds
    s_add_u32 m0, s65, 13312
    s_nop 0
    buffer_load_dwordx4 v7, s[16:19], s59 offen lds
    s_add_u32 m0, s65, 14336
    s_nop 0
    buffer_load_dwordx4 v8, s[16:19], s59 offen lds
    s_add_u32 s67, s67, 40960
    s_cmp_eq_u32 s67, 163840
    s_cselect_b32 s67, 0, s67
    s_add_u32 s66, s66, 1
    s_cmp_lt_u32 s66, 8
    s_cbranch_scc1 L_LD
    v_and_b32 v21, 1, v21
    v_lshlrev_b32 v21, 1, v21
    v_xor_b32 v22, v22, v21
    s_lshl_b32 s58, s57, 7
    v_add_u32 v20, s58, v20
    v_lshl_add_u32 v9, v22, 4, v20
    v_xor_b32 v22, 4, v22
    v_lshl_add_u32 v10, v22, 4, v20
    s_mov_b32 s24, s42
    s_and_b32 s25, s43, 0xffff
    s_mov_b32 s26, 1409024
    s_mov_b32 s27, 0x20000
    s_mov_b32 s20, s48
    s_and_b32 s21, s49, 0xffff
    s_mov_b32 s22, 5636096
    s_mov_b32 s23, 0x20000
    s_mov_b32 s28, s44
    s_and_b32 s29, s45, 0xffff
    s_mov_b32 s30, 2097152
    s_mov_b32 s31, 0x20000
    s_mov_b32 s32, s46
    s_and_b32 s33, s47, 0xffff
    s_mov_b32 s34, 256
    s_mov_b32 s35, 0x20000
    s_mov_b32 s4, s48
    s_and_b32 s5, s49, 0xffff
    s_mov_b32 s6, 5640192
    s_mov_b32 s7, 0x20000
    s_mul_i32 s64, s55, 10240
    s_mul_i32 s65, s55, 81920
    s_lshr_b32 s101, s2, 3
    s_lshl_b32 s101, s101, 2
    s_add_u32 s101, s101, s55
    s_mul_i32 s101, s101, 11008
    v_lshlrev_b32 v30, 7, v1
    v_min_u32 v31, 21, v1
    v_lshlrev_b32 v31, 7, v31
    v_add_u32 v31, 8192, v31
    s_lshl_b32 s58, s50, 4
    s_lshr_b32 s59, s56, 1
    s_lshl_b32 s59, s59, 4
    v_mov_b32 v17, s58
    v_mov_b32 v18, s59
    v_cmp_gt_u32 vcc, 32, v1
    s_nop 1
    v_cndmask_b32 v17, v18, v17, vcc
    s_waitcnt vmcnt(10)
    s_barrier
    buffer_load_dword v20, v17, s[32:35], 0 offen sc1
    buffer_load_dword v32, v30, s[24:27], s101 offen
    s_waitcnt vmcnt(2)
    s_barrier
    buffer_load_dword v33, v31, s[24:27], s101 offen
    s_waitcnt vmcnt(2)
    v_cmp_eq_u32 vcc, 0, v20
    s_cbranch_vccz L_POLLC_DONE
L_POLLC:
    buffer_load_dword v20, v17, s[32:35], 0 offen sc1
    s_add_u32 s3, s3, 1
    s_cmp_gt_u32 s3, 262144
    s_cbranch_scc1 L_POLLC_DONE
    s_waitcnt vmcnt(0)
    v_cmp_eq_u32 vcc, 0, v20
    s_cbranch_vccnz L_POLLC
L_POLLC_DONE:
    s_barrier
    s_mov_b32 s66, 0
L_LW:
    s_add_u32 s58, s98, s66
    s_and_b32 s58, s58, 3
    s_mul_i32 s58, s58, 327680
    s_add_u32 s58, s58, s65
    s_mov_b32 m0, s64
    s_nop 0
    buffer_load_dwordx4 v9, s[24:27], s58 offen lds
    s_add_u32 m0, s64, 1024
    s_add_u32 s58, s58, 8192
    buffer_load_dwordx4 v10, s[24:27], s58 offen lds
    s_add_u32 m0, s64, 2048
    s_add_u32 s58, s58, 8192
    buffer_load_dwordx4 v9, s[24:27], s58 offen lds
    s_add_u32 m0, s64, 3072
    s_add_u32 s58, s58, 8192
    buffer_load_dwordx4 v10, s[24:27], s58 offen lds
    s_add_u32 m0, s64, 4096
    s_add_u32 s58, s58, 8192
    buffer_load_dwordx4 v9, s[24:27], s58 offen lds
    s_add_u32 m0, s64, 5120
    s_add_u32 s58, s58, 8192
    buffer_load_dwordx4 v10, s[24:27], s58 offen lds
    s_add_u32 m0, s64, 6144
    s_add_u32 s58, s58, 8192
    buffer_load_dwordx4 v9, s[24:27], s58 offen lds
    s_add_u32 m0, s64, 7168
    s_add_u32 s58, s58, 8192
    buffer_load_dwordx4 v10, s[24:27], s58 offen lds
    s_add_u32 m0, s64, 8192
    s_add_u32 s58, s58, 8192
    buffer_load_dwordx4 v9, s[24:27], s58 offen lds
    s_add_u32 m0, s64, 9216
    s_add_u32 s58, s58, 8192
    buffer_load_dwordx4 v10, s[24:27], s58 offen lds
    s_add_u32 s64, s64, 40960
    s_add_u32 s66, s66, 1
    s_cmp_lt_u32 s66, 4
    s_cbranch_scc1 L_LW
    s_add_u32 s58, s55, 40
    s_lshl_b32 s58, s58, 15
    buffer_load_dwordx4 v[80:83], v9, s[24:27], s58 offen
    s_add_u32 s58, s58, 8192
    buffer_load_dwordx4 v[84:87], v10, s[24:27], s58 offen
    s_add_u32 s58, s58, 8192
    buffer_load_dwordx4 v[88:91], v9, s[24:27], s58 offen
    s_add_u32 s58, s58, 8192
    buffer_load_dwordx4 v[92:95], v10, s[24:27], s58 offen
    s_branch L_G2
    .p2align 6
L_COMPUTE:
    s_and_b32 s58, s2, 7
    s_lshr_b32 s51, s58, 1
    s_lshl_b32 s51, s51, 2
    s_add_u32 s51, s51, s61
    s_mul_i32 s52, s51, 43
    s_add_u32 s53, s52, 43
    s_lshr_b32 s52, s52, 4
    s_lshr_b32 s53, s53, 4
    s_sub_u32 s53, s53, s52
    s_lshl_b32 s56, s58, 2
    s_add_u32 s56, s56, s61
    s_mov_b32 s98, s56
    s_mov_b32 s3, 0
    s_mov_b32 s100, s57
    s_and_b32 s62, s55, 1
    s_lshr_b32 s63, s55, 1
    v_and_b32 v20, 15, v1
    v_lshrrev_b32 v21, 4, v1
    v_bfe_u32 v22, v20, 1, 3
    v_xor_b32 v22, v22, v21
    v_lshlrev_b32 v22, 4, v22
    v_lshl_add_u32 v22, v20, 7, v22
    s_lshl_b32 s58, s62, 13
    v_add_u32 v2, s58, v22
    v_xor_b32 v3, 64, v2
    v_mov_b32 v192, v2
    v_mov_b32 v193, v3
    v_bfe_u32 v22, v1, 2, 2
    v_lshl_add_u32 v22, v21, 3, v22
    v_mul_u32_u24 v22, 192, v22
    v_and_b32 v23, 3, v1
    v_lshl_add_u32 v22, v23, 3, v22
    v_add_u32 v22, 16384, v22
    v_and_b32 v23, 1, v21
    s_mul_i32 s64, s63, s53
    s_add_u32 s58, s64, 0
    v_xor_b32 v24, s58, v23
    v_lshl_add_u32 v6, v24, 5, v22
    v_mov_b32 v194, v6
    s_add_u32 s58, s64, 1
    v_xor_b32 v24, s58, v23
    v_lshl_add_u32 v7, v24, 5, v22
    v_mov_b32 v195, v7
    s_add_u32 s58, s64, 2
    v_xor_b32 v24, s58, v23
    v_lshl_add_u32 v8, v24, 5, v22
    v_mov_b32 v196, v8
    v_lshlrev_b32 v24, 10, v23
    v_lshrrev_b32 v25, 1, v21
    v_lshl_add_u32 v24, v25, 8, v24
    v_lshl_add_u32 v24, v20, 4, v24
    s_lshl_b32 s58, s50, 3
    s_lshl_b32 s59, s62, 2
    s_add_u32 s58, s58, s59
    s_lshl_b32 s58, s58, 10
    v_add_u32 v12, s58, v24
    v_mov_b32 v14, 0xc0135761
    v_mov_b32 v15, 0xc0135761
    s_mov_b32 s90, 0xbdd2d3e8
    s_mov_b32 s91, 0xbdd2d3e8
    s_mov_b32 s92, 1.0
    s_mov_b32 s93, 1.0
    s_lshl_b32 s60, s52, 1
    s_add_u32 s60, s60, s64
    s_add_u32 s58, s60, 0
    s_lshr_b32 s59, s58, 1
    s_lshl_b32 s59, s59, 17
    s_and_b32 s58, s58, 1
    s_lshl_b32 s58, s58, 9
    s_add_u32 s94, s58, s59
    s_add_u32 s58, s60, 1
    s_lshr_b32 s59, s58, 1
    s_lshl_b32 s59, s59, 17
    s_and_b32 s58, s58, 1
    s_lshl_b32 s58, s58, 9
    s_add_u32 s95, s58, s59
    s_add_u32 s58, s60, 2
    s_lshr_b32 s59, s58, 1
    s_lshl_b32 s59, s59, 17
    s_and_b32 s58, s58, 1
    s_lshl_b32 s58, s58, 9
    s_add_u32 s96, s58, s59
    s_lshl_b32 s61, s50, 1
    s_add_u32 s61, s61, s62
    s_lshl_b32 s61, s61, 7
    s_lshl_b32 s58, s51, 1
    s_add_u32 s58, s58, s63
    s_lshl_b32 s58, s58, 2
    s_add_u32 s61, s61, s58
    s_add_u32 s61, s61, 5636096
    v_mov_b32 v13, 0
    s_waitcnt lgkmcnt(0)
    s_mov_b32 s20, s48
    s_and_b32 s21, s49, 0xffff
    s_mov_b32 s22, 5636096
    s_mov_b32 s23, 0x20000
    s_mov_b32 s28, s44
    s_and_b32 s29, s45, 0xffff
    s_mov_b32 s30, 2097152
    s_mov_b32 s31, 0x20000
    s_mov_b32 s32, s46
    s_and_b32 s33, s47, 0xffff
    s_mov_b32 s34, 256
    s_mov_b32 s35, 0x20000
    s_mov_b32 s4, s48
    s_and_b32 s5, s49, 0xffff
    s_mov_b32 s6, 5640192
    s_mov_b32 s7, 0x20000
    s_lshl_b32 s97, s51, 3
    s_add_u32 s97, s97, s54
    s_cmp_lg_u32 s97, 4
    s_cbranch_scc1 L_NOCLR
    v_lshlrev_b32 v24, 2, v1
    buffer_store_dword v13, v24, s[4:7], s61 offen sc1
L_NOCLR:
    s_setprio 3
    v_mov_b32 v96, 0
    v_mov_b32 v97, 0
    v_mov_b32 v98, 0
    v_mov_b32 v99, 0
    v_mov_b32 v100, 0
    v_mov_b32 v101, 0
    v_mov_b32 v102, 0
    v_mov_b32 v103, 0
    v_mov_b32 v104, 0
    v_mov_b32 v105, 0
    v_mov_b32 v106, 0
    v_mov_b32 v107, 0
    v_mov_b32 v108, 0
    v_mov_b32 v109, 0
    v_mov_b32 v110, 0
    v_mov_b32 v111, 0
    v_mov_b32 v112, 0
    v_mov_b32 v113, 0
    v_mov_b32 v114, 0
    v_mov_b32 v115, 0
    v_mov_b32 v116, 0
    v_mov_b32 v117, 0
    v_mov_b32 v118, 0
    v_mov_b32 v119, 0
    v_mov_b32 v120, 0
    v_mov_b32 v121, 0
    v_mov_b32 v122, 0
    v_mov_b32 v123, 0
    v_mov_b32 v124, 0
    v_mov_b32 v125, 0
    v_mov_b32 v126, 0
    v_mov_b32 v127, 0
    v_mov_b32 v128, 0
    v_mov_b32 v129, 0
    v_mov_b32 v130, 0
    v_mov_b32 v131, 0
    v_mov_b32 v132, 0
    v_mov_b32 v133, 0
    v_mov_b32 v134, 0
    v_mov_b32 v135, 0
    v_mov_b32 v136, 0
    v_mov_b32 v137, 0
    v_mov_b32 v138, 0
    v_mov_b32 v139, 0
    v_mov_b32 v140, 0
    v_mov_b32 v141, 0
    v_mov_b32 v142, 0
    v_mov_b32 v143, 0
    v_mov_b32 v144, 0
    v_mov_b32 v145, 0
    v_mov_b32 v146, 0
    v_mov_b32 v147, 0
    v_mov_b32 v148, 0
    v_mov_b32 v149, 0
    v_mov_b32 v150, 0
    v_mov_b32 v151, 0
    v_mov_b32 v152, 0
    v_mov_b32 v153, 0
    v_mov_b32 v154, 0
    v_mov_b32 v155, 0
    v_mov_b32 v156, 0
    v_mov_b32 v157, 0
    v_mov_b32 v158, 0
    v_mov_b32 v159, 0
    v_mov_b32 v160, 0
    v_mov_b32 v161, 0
    v_mov_b32 v162, 0
    v_mov_b32 v163, 0
    v_mov_b32 v164, 0
    v_mov_b32 v165, 0
    v_mov_b32 v166, 0
    v_mov_b32 v167, 0
    v_mov_b32 v168, 0
    v_mov_b32 v169, 0
    v_mov_b32 v170, 0
    v_mov_b32 v171, 0
    v_mov_b32 v172, 0
    v_mov_b32 v173, 0
    v_mov_b32 v174, 0
    v_mov_b32 v175, 0
    v_mov_b32 v176, 0
    v_mov_b32 v177, 0
    v_mov_b32 v178, 0
    v_mov_b32 v179, 0
    v_mov_b32 v180, 0
    v_mov_b32 v181, 0
    v_mov_b32 v182, 0
    v_mov_b32 v183, 0
    v_mov_b32 v184, 0
    v_mov_b32 v185, 0
    v_mov_b32 v186, 0
    v_mov_b32 v187, 0
    v_mov_b32 v188, 0
    v_mov_b32 v189, 0
    v_mov_b32 v190, 0
    v_mov_b32 v191, 0
    s_mov_b32 s66, 0
    s_mov_b32 s67, 0
    s_barrier
    ds_read_b64_tr_b16 v[16:17], v6 offset:0
    ds_read_b64_tr_b16 v[18:19], v6 offset:768
    ds_read_b128 v[64:67], v2 offset:0
    ds_read_b128 v[68:71], v2 offset:2048
    ds_read_b128 v[72:75], v2 offset:4096
    ds_read_b128 v[76:79], v2 offset:6144
    ds_read_b64_tr_b16 v[20:21], v6 offset:12288
    ds_read_b64_tr_b16 v[22:23], v6 offset:13056
    ds_read_b64_tr_b16 v[24:25], v7 offset:0
    ds_read_b64_tr_b16 v[26:27], v7 offset:768
    ds_read_b64_tr_b16 v[28:29], v7 offset:12288
    ds_read_b64_tr_b16 v[30:31], v7 offset:13056
    ds_read_b64_tr_b16 v[32:33], v8 offset:0
    ds_read_b64_tr_b16 v[34:35], v8 offset:768
    ds_read_b64_tr_b16 v[36:37], v8 offset:12288
    ds_read_b64_tr_b16 v[38:39], v8 offset:13056
    .p2align 3
L_MAIN:
    s_waitcnt lgkmcnt(13)
    v_mfma_f32_16x16x32_bf16 v[96:99], v[16:19], v[64:67], v[96:99]
    ds_read_b64_tr_b16 v[40:41], v6 offset:6144
    ds_read_b64_tr_b16 v[42:43], v6 offset:6912
    s_waitcnt lgkmcnt(14)
    v_mfma_f32_16x16x32_bf16 v[100:103], v[16:19], v[68:71], v[100:103]
    s_waitcnt lgkmcnt(13)
    v_mfma_f32_16x16x32_bf16 v[104:107], v[16:19], v[72:75], v[104:107]
    ds_read_b128 v[80:83], v3 offset:0
    ds_read_b128 v[84:87], v3 offset:2048
    s_waitcnt lgkmcnt(14)
    v_mfma_f32_16x16x32_bf16 v[108:111], v[16:19], v[76:79], v[108:111]
    s_waitcnt lgkmcnt(12)
    v_mfma_f32_16x16x32_bf16 v[112:115], v[20:23], v[64:67], v[112:115]
    ds_read_b128 v[88:91], v3 offset:4096
    ds_read_b128 v[92:95], v3 offset:6144
    v_mfma_f32_16x16x32_bf16 v[116:119], v[20:23], v[68:71], v[116:119]
    v_mfma_f32_16x16x32_bf16 v[120:123], v[20:23], v[72:75], v[120:123]
    ds_read_b64_tr_b16 v[44:45], v6 offset:18432
    ds_read_b64_tr_b16 v[46:47], v6 offset:19200
    v_mfma_f32_16x16x32_bf16 v[124:127], v[20:23], v[76:79], v[124:127]
    s_waitcnt lgkmcnt(14)
    v_mfma_f32_16x16x32_bf16 v[128:131], v[24:27], v[64:67], v[128:131]
    ds_read_b64_tr_b16 v[48:49], v7 offset:6144
    ds_read_b64_tr_b16 v[50:51], v7 offset:6912
    v_mfma_f32_16x16x32_bf16 v[132:135], v[24:27], v[68:71], v[132:135]
    v_mfma_f32_16x16x32_bf16 v[136:139], v[24:27], v[72:75], v[136:139]
    v_mfma_f32_16x16x32_bf16 v[140:143], v[24:27], v[76:79], v[140:143]
    s_waitcnt lgkmcnt(14)
    v_mfma_f32_16x16x32_bf16 v[144:147], v[28:31], v[64:67], v[144:147]
    ds_read_b64_tr_b16 v[52:53], v7 offset:18432
    ds_read_b64_tr_b16 v[54:55], v7 offset:19200
    v_mfma_f32_16x16x32_bf16 v[148:151], v[28:31], v[68:71], v[148:151]
    v_mfma_f32_16x16x32_bf16 v[152:155], v[28:31], v[72:75], v[152:155]
    v_mfma_f32_16x16x32_bf16 v[156:159], v[28:31], v[76:79], v[156:159]
    s_waitcnt lgkmcnt(14)
    v_mfma_f32_16x16x32_bf16 v[160:163], v[32:35], v[64:67], v[160:163]
    ds_read_b64_tr_b16 v[56:57], v8 offset:6144
    ds_read_b64_tr_b16 v[58:59], v8 offset:6912
    v_mfma_f32_16x16x32_bf16 v[164:167], v[32:35], v[68:71], v[164:167]
    v_mfma_f32_16x16x32_bf16 v[168:171], v[32:35], v[72:75], v[168:171]
    v_mfma_f32_16x16x32_bf16 v[172:175], v[32:35], v[76:79], v[172:175]
    s_waitcnt lgkmcnt(14)
    v_mfma_f32_16x16x32_bf16 v[176:179], v[36:39], v[64:67], v[176:179]
    ds_read_b64_tr_b16 v[60:61], v8 offset:18432
    ds_read_b64_tr_b16 v[62:63], v8 offset:19200
    v_mfma_f32_16x16x32_bf16 v[180:183], v[36:39], v[68:71], v[180:183]
    v_mfma_f32_16x16x32_bf16 v[184:187], v[36:39], v[72:75], v[184:187]
    v_mfma_f32_16x16x32_bf16 v[188:191], v[36:39], v[76:79], v[188:191]
    s_waitcnt lgkmcnt(13)
    v_mfma_f32_16x16x32_bf16 v[96:99], v[40:43], v[80:83], v[96:99]
    s_waitcnt lgkmcnt(12)
    v_mfma_f32_16x16x32_bf16 v[100:103], v[40:43], v[84:87], v[100:103]
    s_waitcnt lgkmcnt(11)
    v_mfma_f32_16x16x32_bf16 v[104:107], v[40:43], v[88:91], v[104:107]
    s_waitcnt lgkmcnt(10)
    v_mfma_f32_16x16x32_bf16 v[108:111], v[40:43], v[92:95], v[108:111]
    s_waitcnt lgkmcnt(8)
    v_mfma_f32_16x16x32_bf16 v[112:115], v[44:47], v[80:83], v[112:115]
    v_mfma_f32_16x16x32_bf16 v[116:119], v[44:47], v[84:87], v[116:119]
    v_mfma_f32_16x16x32_bf16 v[120:123], v[44:47], v[88:91], v[120:123]
    v_mfma_f32_16x16x32_bf16 v[124:127], v[44:47], v[92:95], v[124:127]
    s_add_u32 s67, s67, 40960
    s_cmp_eq_u32 s67, 163840
    s_cselect_b32 s67, 0, s67
    s_waitcnt lgkmcnt(6)
    v_mfma_f32_16x16x32_bf16 v[128:131], v[48:51], v[80:83], v[128:131]
    v_add_u32 v2, s67, v192
    v_mfma_f32_16x16x32_bf16 v[132:135], v[48:51], v[84:87], v[132:135]
    v_add_u32 v3, s67, v193
    v_mfma_f32_16x16x32_bf16 v[136:139], v[48:51], v[88:91], v[136:139]
    v_add_u32 v6, s67, v194
    v_mfma_f32_16x16x32_bf16 v[140:143], v[48:51], v[92:95], v[140:143]
    v_add_u32 v7, s67, v195
    s_waitcnt lgkmcnt(4)
    v_mfma_f32_16x16x32_bf16 v[144:147], v[52:55], v[80:83], v[144:147]
    v_add_u32 v8, s67, v196
    v_mfma_f32_16x16x32_bf16 v[148:151], v[52:55], v[84:87], v[148:151]
    v_mfma_f32_16x16x32_bf16 v[152:155], v[52:55], v[88:91], v[152:155]
    v_mfma_f32_16x16x32_bf16 v[156:159], v[52:55], v[92:95], v[156:159]
    s_cmp_eq_u32 s66, 7
    s_cbranch_scc1 L_CNT_RET
    s_barrier
    s_cmp_lg_u32 s97, 4
    s_cbranch_scc0 L_CNT
L_CNT_RET:
    s_waitcnt lgkmcnt(2)
    v_mfma_f32_16x16x32_bf16 v[160:163], v[56:59], v[80:83], v[160:163]
    ds_read_b64_tr_b16 v[16:17], v6 offset:0
    ds_read_b64_tr_b16 v[18:19], v6 offset:768
    v_mfma_f32_16x16x32_bf16 v[164:167], v[56:59], v[84:87], v[164:167]
    ds_read_b128 v[64:67], v2 offset:0
    ds_read_b128 v[68:71], v2 offset:2048
    v_mfma_f32_16x16x32_bf16 v[168:171], v[56:59], v[88:91], v[168:171]
    ds_read_b128 v[72:75], v2 offset:4096
    ds_read_b128 v[76:79], v2 offset:6144
    v_mfma_f32_16x16x32_bf16 v[172:175], v[56:59], v[92:95], v[172:175]
    ds_read_b64_tr_b16 v[20:21], v6 offset:12288
    ds_read_b64_tr_b16 v[22:23], v6 offset:13056
    s_waitcnt lgkmcnt(8)
    v_mfma_f32_16x16x32_bf16 v[176:179], v[60:63], v[80:83], v[176:179]
    ds_read_b64_tr_b16 v[24:25], v7 offset:0
    ds_read_b64_tr_b16 v[26:27], v7 offset:768
    v_mfma_f32_16x16x32_bf16 v[180:183], v[60:63], v[84:87], v[180:183]
    ds_read_b64_tr_b16 v[28:29], v7 offset:12288
    ds_read_b64_tr_b16 v[30:31], v7 offset:13056
    v_mfma_f32_16x16x32_bf16 v[184:187], v[60:63], v[88:91], v[184:187]
    ds_read_b64_tr_b16 v[32:33], v8 offset:0
    ds_read_b64_tr_b16 v[34:35], v8 offset:768
    v_mfma_f32_16x16x32_bf16 v[188:191], v[60:63], v[92:95], v[188:191]
    ds_read_b64_tr_b16 v[36:37], v8 offset:12288
    ds_read_b64_tr_b16 v[38:39], v8 offset:13056
    s_add_u32 s66, s66, 1
    s_cmp_lt_u32 s66, 8
    s_cbranch_scc1 L_MAIN
    s_waitcnt lgkmcnt(0)
    s_barrier
    s_nop 7
    v_pk_mul_f32 v[16:17], v[96:97], v[96:97]
    v_pk_mul_f32 v[18:19], v[98:99], v[98:99]
    v_pk_mul_f32 v[20:21], v[100:101], v[100:101]
    v_pk_mul_f32 v[22:23], v[102:103], v[102:103]
    v_pk_fma_f32 v[16:17], v[16:17], s[90:91], v[14:15]
    v_pk_fma_f32 v[18:19], v[18:19], s[90:91], v[14:15]
    v_pk_fma_f32 v[20:21], v[20:21], s[90:91], v[14:15]
    v_pk_fma_f32 v[22:23], v[22:23], s[90:91], v[14:15]
    v_pk_mul_f32 v[16:17], v[16:17], v[96:97]
    v_pk_mul_f32 v[18:19], v[18:19], v[98:99]
    v_pk_mul_f32 v[20:21], v[20:21], v[100:101]
    v_pk_mul_f32 v[22:23], v[22:23], v[102:103]
    v_exp_f32 v16, v16
    v_exp_f32 v17, v17
    v_exp_f32 v18, v18
    v_exp_f32 v19, v19
    v_exp_f32 v20, v20
    v_exp_f32 v21, v21
    v_exp_f32 v22, v22
    v_exp_f32 v23, v23
    v_pk_mul_f32 v[24:25], v[96:97], v[112:113]
    v_pk_mul_f32 v[26:27], v[98:99], v[114:115]
    v_pk_mul_f32 v[28:29], v[100:101], v[116:117]
    v_pk_mul_f32 v[30:31], v[102:103], v[118:119]
    v_pk_add_f32 v[16:17], v[16:17], s[92:93]
    v_pk_add_f32 v[18:19], v[18:19], s[92:93]
    v_pk_add_f32 v[20:21], v[20:21], s[92:93]
    v_pk_add_f32 v[22:23], v[22:23], s[92:93]
    v_rcp_f32 v16, v16
    v_rcp_f32 v17, v17
    v_rcp_f32 v18, v18
    v_rcp_f32 v19, v19
    v_rcp_f32 v20, v20
    v_rcp_f32 v21, v21
    v_rcp_f32 v22, v22
    v_rcp_f32 v23, v23
    s_nop 0
    v_pk_mul_f32 v[16:17], v[16:17], v[24:25]
    v_pk_mul_f32 v[18:19], v[18:19], v[26:27]
    v_pk_mul_f32 v[20:21], v[20:21], v[28:29]
    v_pk_mul_f32 v[22:23], v[22:23], v[30:31]
    v_cvt_pk_bf16_f32 v64, v16, v17
    v_cvt_pk_bf16_f32 v65, v18, v19
    v_cvt_pk_bf16_f32 v66, v20, v21
    v_cvt_pk_bf16_f32 v67, v22, v23
    s_nop 1
    v_permlane16_swap_b32 v64, v66
    v_permlane16_swap_b32 v65, v67
    buffer_store_dwordx4 v[64:67], v12, s[20:23], s94 offen offset:0 sc1
    v_pk_mul_f32 v[32:33], v[104:105], v[104:105]
    v_pk_mul_f32 v[34:35], v[106:107], v[106:107]
    v_pk_mul_f32 v[36:37], v[108:109], v[108:109]
    v_pk_mul_f32 v[38:39], v[110:111], v[110:111]
    v_pk_fma_f32 v[32:33], v[32:33], s[90:91], v[14:15]
    v_pk_fma_f32 v[34:35], v[34:35], s[90:91], v[14:15]
    v_pk_fma_f32 v[36:37], v[36:37], s[90:91], v[14:15]
    v_pk_fma_f32 v[38:39], v[38:39], s[90:91], v[14:15]
    v_pk_mul_f32 v[32:33], v[32:33], v[104:105]
    v_pk_mul_f32 v[34:35], v[34:35], v[106:107]
    v_pk_mul_f32 v[36:37], v[36:37], v[108:109]
    v_pk_mul_f32 v[38:39], v[38:39], v[110:111]
    v_exp_f32 v32, v32
    v_exp_f32 v33, v33
    v_exp_f32 v34, v34
    v_exp_f32 v35, v35
    v_exp_f32 v36, v36
    v_exp_f32 v37, v37
    v_exp_f32 v38, v38
    v_exp_f32 v39, v39
    v_pk_mul_f32 v[40:41], v[104:105], v[120:121]
    v_pk_mul_f32 v[42:43], v[106:107], v[122:123]
    v_pk_mul_f32 v[44:45], v[108:109], v[124:125]
    v_pk_mul_f32 v[46:47], v[110:111], v[126:127]
    v_pk_add_f32 v[32:33], v[32:33], s[92:93]
    v_pk_add_f32 v[34:35], v[34:35], s[92:93]
    v_pk_add_f32 v[36:37], v[36:37], s[92:93]
    v_pk_add_f32 v[38:39], v[38:39], s[92:93]
    v_rcp_f32 v32, v32
    v_rcp_f32 v33, v33
    v_rcp_f32 v34, v34
    v_rcp_f32 v35, v35
    v_rcp_f32 v36, v36
    v_rcp_f32 v37, v37
    v_rcp_f32 v38, v38
    v_rcp_f32 v39, v39
    s_nop 0
    v_pk_mul_f32 v[32:33], v[32:33], v[40:41]
    v_pk_mul_f32 v[34:35], v[34:35], v[42:43]
    v_pk_mul_f32 v[36:37], v[36:37], v[44:45]
    v_pk_mul_f32 v[38:39], v[38:39], v[46:47]
    v_cvt_pk_bf16_f32 v68, v32, v33
    v_cvt_pk_bf16_f32 v69, v34, v35
    v_cvt_pk_bf16_f32 v70, v36, v37
    v_cvt_pk_bf16_f32 v71, v38, v39
    s_nop 1
    v_permlane16_swap_b32 v68, v70
    v_permlane16_swap_b32 v69, v71
    buffer_store_dwordx4 v[68:71], v12, s[20:23], s94 offen offset:2048 sc1
    v_pk_mul_f32 v[16:17], v[128:129], v[128:129]
    v_pk_mul_f32 v[18:19], v[130:131], v[130:131]
    v_pk_mul_f32 v[20:21], v[132:133], v[132:133]
    v_pk_mul_f32 v[22:23], v[134:135], v[134:135]
    v_pk_fma_f32 v[16:17], v[16:17], s[90:91], v[14:15]
    v_pk_fma_f32 v[18:19], v[18:19], s[90:91], v[14:15]
    v_pk_fma_f32 v[20:21], v[20:21], s[90:91], v[14:15]
    v_pk_fma_f32 v[22:23], v[22:23], s[90:91], v[14:15]
    v_pk_mul_f32 v[16:17], v[16:17], v[128:129]
    v_pk_mul_f32 v[18:19], v[18:19], v[130:131]
    v_pk_mul_f32 v[20:21], v[20:21], v[132:133]
    v_pk_mul_f32 v[22:23], v[22:23], v[134:135]
    v_exp_f32 v16, v16
    v_exp_f32 v17, v17
    v_exp_f32 v18, v18
    v_exp_f32 v19, v19
    v_exp_f32 v20, v20
    v_exp_f32 v21, v21
    v_exp_f32 v22, v22
    v_exp_f32 v23, v23
    v_pk_mul_f32 v[24:25], v[128:129], v[144:145]
    v_pk_mul_f32 v[26:27], v[130:131], v[146:147]
    v_pk_mul_f32 v[28:29], v[132:133], v[148:149]
    v_pk_mul_f32 v[30:31], v[134:135], v[150:151]
    v_pk_add_f32 v[16:17], v[16:17], s[92:93]
    v_pk_add_f32 v[18:19], v[18:19], s[92:93]
    v_pk_add_f32 v[20:21], v[20:21], s[92:93]
    v_pk_add_f32 v[22:23], v[22:23], s[92:93]
    v_rcp_f32 v16, v16
    v_rcp_f32 v17, v17
    v_rcp_f32 v18, v18
    v_rcp_f32 v19, v19
    v_rcp_f32 v20, v20
    v_rcp_f32 v21, v21
    v_rcp_f32 v22, v22
    v_rcp_f32 v23, v23
    s_nop 0
    v_pk_mul_f32 v[16:17], v[16:17], v[24:25]
    v_pk_mul_f32 v[18:19], v[18:19], v[26:27]
    v_pk_mul_f32 v[20:21], v[20:21], v[28:29]
    v_pk_mul_f32 v[22:23], v[22:23], v[30:31]
    v_cvt_pk_bf16_f32 v72, v16, v17
    v_cvt_pk_bf16_f32 v73, v18, v19
    v_cvt_pk_bf16_f32 v74, v20, v21
    v_cvt_pk_bf16_f32 v75, v22, v23
    s_nop 1
    v_permlane16_swap_b32 v72, v74
    v_permlane16_swap_b32 v73, v75
    buffer_store_dwordx4 v[72:75], v12, s[20:23], s95 offen offset:0 sc1
    v_pk_mul_f32 v[32:33], v[136:137], v[136:137]
    v_pk_mul_f32 v[34:35], v[138:139], v[138:139]
    v_pk_mul_f32 v[36:37], v[140:141], v[140:141]
    v_pk_mul_f32 v[38:39], v[142:143], v[142:143]
    v_pk_fma_f32 v[32:33], v[32:33], s[90:91], v[14:15]
    v_pk_fma_f32 v[34:35], v[34:35], s[90:91], v[14:15]
    v_pk_fma_f32 v[36:37], v[36:37], s[90:91], v[14:15]
    v_pk_fma_f32 v[38:39], v[38:39], s[90:91], v[14:15]
    v_pk_mul_f32 v[32:33], v[32:33], v[136:137]
    v_pk_mul_f32 v[34:35], v[34:35], v[138:139]
    v_pk_mul_f32 v[36:37], v[36:37], v[140:141]
    v_pk_mul_f32 v[38:39], v[38:39], v[142:143]
    v_exp_f32 v32, v32
    v_exp_f32 v33, v33
    v_exp_f32 v34, v34
    v_exp_f32 v35, v35
    v_exp_f32 v36, v36
    v_exp_f32 v37, v37
    v_exp_f32 v38, v38
    v_exp_f32 v39, v39
    v_pk_mul_f32 v[40:41], v[136:137], v[152:153]
    v_pk_mul_f32 v[42:43], v[138:139], v[154:155]
    v_pk_mul_f32 v[44:45], v[140:141], v[156:157]
    v_pk_mul_f32 v[46:47], v[142:143], v[158:159]
    v_pk_add_f32 v[32:33], v[32:33], s[92:93]
    v_pk_add_f32 v[34:35], v[34:35], s[92:93]
    v_pk_add_f32 v[36:37], v[36:37], s[92:93]
    v_pk_add_f32 v[38:39], v[38:39], s[92:93]
    v_rcp_f32 v32, v32
    v_rcp_f32 v33, v33
    v_rcp_f32 v34, v34
    v_rcp_f32 v35, v35
    v_rcp_f32 v36, v36
    v_rcp_f32 v37, v37
    v_rcp_f32 v38, v38
    v_rcp_f32 v39, v39
    s_nop 0
    v_pk_mul_f32 v[32:33], v[32:33], v[40:41]
    v_pk_mul_f32 v[34:35], v[34:35], v[42:43]
    v_pk_mul_f32 v[36:37], v[36:37], v[44:45]
    v_pk_mul_f32 v[38:39], v[38:39], v[46:47]
    v_cvt_pk_bf16_f32 v76, v32, v33
    v_cvt_pk_bf16_f32 v77, v34, v35
    v_cvt_pk_bf16_f32 v78, v36, v37
    v_cvt_pk_bf16_f32 v79, v38, v39
    s_nop 1
    v_permlane16_swap_b32 v76, v78
    v_permlane16_swap_b32 v77, v79
    buffer_store_dwordx4 v[76:79], v12, s[20:23], s95 offen offset:2048 sc1
    s_cmp_lt_u32 s53, 3
    s_cbranch_scc1 L_EPI_DONE
    v_pk_mul_f32 v[16:17], v[160:161], v[160:161]
    v_pk_mul_f32 v[18:19], v[162:163], v[162:163]
    v_pk_mul_f32 v[20:21], v[164:165], v[164:165]
    v_pk_mul_f32 v[22:23], v[166:167], v[166:167]
    v_pk_fma_f32 v[16:17], v[16:17], s[90:91], v[14:15]
    v_pk_fma_f32 v[18:19], v[18:19], s[90:91], v[14:15]
    v_pk_fma_f32 v[20:21], v[20:21], s[90:91], v[14:15]
    v_pk_fma_f32 v[22:23], v[22:23], s[90:91], v[14:15]
    v_pk_mul_f32 v[16:17], v[16:17], v[160:161]
    v_pk_mul_f32 v[18:19], v[18:19], v[162:163]
    v_pk_mul_f32 v[20:21], v[20:21], v[164:165]
    v_pk_mul_f32 v[22:23], v[22:23], v[166:167]
    v_exp_f32 v16, v16
    v_exp_f32 v17, v17
    v_exp_f32 v18, v18
    v_exp_f32 v19, v19
    v_exp_f32 v20, v20
    v_exp_f32 v21, v21
    v_exp_f32 v22, v22
    v_exp_f32 v23, v23
    v_pk_mul_f32 v[24:25], v[160:161], v[176:177]
    v_pk_mul_f32 v[26:27], v[162:163], v[178:179]
    v_pk_mul_f32 v[28:29], v[164:165], v[180:181]
    v_pk_mul_f32 v[30:31], v[166:167], v[182:183]
    v_pk_add_f32 v[16:17], v[16:17], s[92:93]
    v_pk_add_f32 v[18:19], v[18:19], s[92:93]
    v_pk_add_f32 v[20:21], v[20:21], s[92:93]
    v_pk_add_f32 v[22:23], v[22:23], s[92:93]
    v_rcp_f32 v16, v16
    v_rcp_f32 v17, v17
    v_rcp_f32 v18, v18
    v_rcp_f32 v19, v19
    v_rcp_f32 v20, v20
    v_rcp_f32 v21, v21
    v_rcp_f32 v22, v22
    v_rcp_f32 v23, v23
    s_nop 0
    v_pk_mul_f32 v[16:17], v[16:17], v[24:25]
    v_pk_mul_f32 v[18:19], v[18:19], v[26:27]
    v_pk_mul_f32 v[20:21], v[20:21], v[28:29]
    v_pk_mul_f32 v[22:23], v[22:23], v[30:31]
    v_cvt_pk_bf16_f32 v80, v16, v17
    v_cvt_pk_bf16_f32 v81, v18, v19
    v_cvt_pk_bf16_f32 v82, v20, v21
    v_cvt_pk_bf16_f32 v83, v22, v23
    s_nop 1
    v_permlane16_swap_b32 v80, v82
    v_permlane16_swap_b32 v81, v83
    buffer_store_dwordx4 v[80:83], v12, s[20:23], s96 offen offset:0 sc1
    v_pk_mul_f32 v[32:33], v[168:169], v[168:169]
    v_pk_mul_f32 v[34:35], v[170:171], v[170:171]
    v_pk_mul_f32 v[36:37], v[172:173], v[172:173]
    v_pk_mul_f32 v[38:39], v[174:175], v[174:175]
    v_pk_fma_f32 v[32:33], v[32:33], s[90:91], v[14:15]
    v_pk_fma_f32 v[34:35], v[34:35], s[90:91], v[14:15]
    v_pk_fma_f32 v[36:37], v[36:37], s[90:91], v[14:15]
    v_pk_fma_f32 v[38:39], v[38:39], s[90:91], v[14:15]
    v_pk_mul_f32 v[32:33], v[32:33], v[168:169]
    v_pk_mul_f32 v[34:35], v[34:35], v[170:171]
    v_pk_mul_f32 v[36:37], v[36:37], v[172:173]
    v_pk_mul_f32 v[38:39], v[38:39], v[174:175]
    v_exp_f32 v32, v32
    v_exp_f32 v33, v33
    v_exp_f32 v34, v34
    v_exp_f32 v35, v35
    v_exp_f32 v36, v36
    v_exp_f32 v37, v37
    v_exp_f32 v38, v38
    v_exp_f32 v39, v39
    v_pk_mul_f32 v[40:41], v[168:169], v[184:185]
    v_pk_mul_f32 v[42:43], v[170:171], v[186:187]
    v_pk_mul_f32 v[44:45], v[172:173], v[188:189]
    v_pk_mul_f32 v[46:47], v[174:175], v[190:191]
    v_pk_add_f32 v[32:33], v[32:33], s[92:93]
    v_pk_add_f32 v[34:35], v[34:35], s[92:93]
    v_pk_add_f32 v[36:37], v[36:37], s[92:93]
    v_pk_add_f32 v[38:39], v[38:39], s[92:93]
    v_rcp_f32 v32, v32
    v_rcp_f32 v33, v33
    v_rcp_f32 v34, v34
    v_rcp_f32 v35, v35
    v_rcp_f32 v36, v36
    v_rcp_f32 v37, v37
    v_rcp_f32 v38, v38
    v_rcp_f32 v39, v39
    s_nop 0
    v_pk_mul_f32 v[32:33], v[32:33], v[40:41]
    v_pk_mul_f32 v[34:35], v[34:35], v[42:43]
    v_pk_mul_f32 v[36:37], v[36:37], v[44:45]
    v_pk_mul_f32 v[38:39], v[38:39], v[46:47]
    v_cvt_pk_bf16_f32 v84, v32, v33
    v_cvt_pk_bf16_f32 v85, v34, v35
    v_cvt_pk_bf16_f32 v86, v36, v37
    v_cvt_pk_bf16_f32 v87, v38, v39
    s_nop 1
    v_permlane16_swap_b32 v84, v86
    v_permlane16_swap_b32 v85, v87
    buffer_store_dwordx4 v[84:87], v12, s[20:23], s96 offen offset:2048 sc1
L_EPI_DONE:
    s_waitcnt vmcnt(0)
    v_mov_b32 v88, 1
    s_mov_b64 exec, 1
    buffer_store_dword v88, v13, s[4:7], s61 offen sc1
    s_mov_b64 exec, -1
    s_setprio 0
L_G2:
    s_lshr_b32 s63, s54, 2
    v_lshrrev_b32 v21, 4, v1
    v_and_b32 v23, 1, v21
    v_bfe_u32 v22, v1, 2, 2
    v_lshl_add_u32 v22, v21, 3, v22
    v_lshlrev_b32 v22, 7, v22
    v_and_b32 v24, 1, v1
    v_lshl_add_u32 v22, v24, 3, v22
    v_bfe_u32 v24, v1, 1, 1
    v_lshl_add_u32 v22, v24, 4, v22
    s_mul_i32 s58, s55, 40960
    v_add_u32 v22, s58, v22
    v_bfe_u32 v24, v1, 3, 1
    v_lshl_add_u32 v24, v23, 1, v24
    v_lshlrev_b32 v24, 1, v24
    v_xor_b32 v25, 0, v24
    v_lshl_add_u32 v2, v25, 4, v22
    v_xor_b32 v25, 2, v24
    v_lshl_add_u32 v3, v25, 4, v22
    v_xor_b32 v25, 4, v24
    v_lshl_add_u32 v4, v25, 4, v22
    v_xor_b32 v25, 6, v24
    v_lshl_add_u32 v5, v25, 4, v22
    v_lshlrev_b32 v14, 4, v1
    s_mov_b32 s65, s57
    s_mov_b32 s62, s65
    s_lshl_b32 s60, s65, 12
    s_add_u32 s58, s58, s60
    v_add_u32 v7, s58, v14
    s_add_u32 s64, s55, s98
    s_and_b32 s64, s64, 3
    s_mul_i32 s64, s64, 10
    s_mul_i32 s58, s55, 40960
    s_lshl_b32 s59, s63, 13
    s_add_u32 s58, s58, s59
    v_add_u32 v15, s58, v14
    s_lshl_b32 s58, s56, 12
    s_lshl_b32 s59, s63, 11
    s_add_u32 s58, s58, s59
    v_add_u32 v6, s58, v14
    v_and_b32 v24, 31, v1
    v_lshlrev_b32 v13, 2, v24
    v_lshrrev_b32 v24, 1, v24
    v_mul_u32_u24 v25, 43, v24
    v_add_u32 v26, 43, v25
    v_lshrrev_b32 v25, 4, v25
    v_lshrrev_b32 v26, 4, v26
    s_add_u32 s58, s64, 10
    v_cmp_gt_u32 s[90:91], s58, v25
    v_cmp_lt_u32 s[92:93], s64, v26
    s_and_b64 s[90:91], s[90:91], s[92:93]
    v_cmp_eq_u32 s[92:93], 15, v24
    s_or_b64 s[90:91], s[90:91], s[92:93]
    s_lshl_b32 s61, s56, 7
    s_add_u32 s61, s61, 5636096
    s_add_u32 s58, s64, s65
    s_lshl_b32 s70, s58, 17
    s_add_u32 s65, s65, 1
    s_cmp_eq_u32 s65, 10
    s_cselect_b32 s65, 0, s65
    s_add_u32 s58, s64, s65
    s_lshl_b32 s71, s58, 17
    s_add_u32 s65, s65, 1
    s_cmp_eq_u32 s65, 10
    s_cselect_b32 s65, 0, s65
    s_add_u32 s58, s64, s65
    s_lshl_b32 s72, s58, 17
    s_add_u32 s65, s65, 1
    s_cmp_eq_u32 s65, 10
    s_cselect_b32 s65, 0, s65
    s_add_u32 s58, s64, s65
    s_lshl_b32 s73, s58, 17
    s_add_u32 s65, s65, 1
    s_cmp_eq_u32 s65, 10
    s_cselect_b32 s65, 0, s65
    s_add_u32 s58, s64, s65
    s_lshl_b32 s74, s58, 17
    s_add_u32 s65, s65, 1
    s_cmp_eq_u32 s65, 10
    s_cselect_b32 s65, 0, s65
    s_add_u32 s58, s64, s65
    s_lshl_b32 s75, s58, 17
    s_add_u32 s65, s65, 1
    s_cmp_eq_u32 s65, 10
    s_cselect_b32 s65, 0, s65
    s_add_u32 s58, s64, s65
    s_lshl_b32 s76, s58, 17
    s_add_u32 s65, s65, 1
    s_cmp_eq_u32 s65, 10
    s_cselect_b32 s65, 0, s65
    s_add_u32 s58, s64, s65
    s_lshl_b32 s77, s58, 17
    s_add_u32 s65, s65, 1
    s_cmp_eq_u32 s65, 10
    s_cselect_b32 s65, 0, s65
    s_add_u32 s58, s64, s65
    s_lshl_b32 s78, s58, 17
    s_add_u32 s65, s65, 1
    s_cmp_eq_u32 s65, 10
    s_cselect_b32 s65, 0, s65
    s_add_u32 s58, s64, s65
    s_lshl_b32 s79, s58, 17
    s_add_u32 s65, s65, 1
    s_cmp_eq_u32 s65, 10
    s_cselect_b32 s65, 0, s65
    s_add_u32 s58, s55, 40
    s_lshl_b32 s80, s58, 17
    s_lshl_b32 s59, s62, 12
    s_add_u32 s62, s62, 1
    s_cmp_eq_u32 s62, 10
    s_cselect_b32 s62, 0, s62
    v_add_u32 v8, s59, v2
    v_add_u32 v9, s59, v3
    v_add_u32 v10, s59, v4
    v_add_u32 v11, s59, v5
    s_waitcnt vmcnt(0)
    s_barrier
    ds_read_b64_tr_b16 v[16:17], v8 offset:0
    ds_read_b64_tr_b16 v[18:19], v8 offset:512
    ds_read_b64_tr_b16 v[20:21], v9 offset:0
    ds_read_b64_tr_b16 v[22:23], v9 offset:512
    ds_read_b64_tr_b16 v[24:25], v10 offset:0
    ds_read_b64_tr_b16 v[26:27], v10 offset:512
    ds_read_b64_tr_b16 v[28:29], v11 offset:0
    ds_read_b64_tr_b16 v[30:31], v11 offset:512
    s_waitcnt lgkmcnt(0)
    s_barrier
    s_cmp_ge_u32 s54, 4
    s_cbranch_scc1 L_NOXW
    ds_write_b128 v7, v[80:83] offset:0
    ds_write_b128 v7, v[84:87] offset:1024
    ds_write_b128 v7, v[88:91] offset:2048
    ds_write_b128 v7, v[92:95] offset:3072
    s_waitcnt lgkmcnt(0)
L_NOXW:
    s_barrier
L_POLL:
    buffer_load_dword v12, v13, s[4:7], s61 offen sc1
    s_add_u32 s3, s3, 1
    s_cmp_gt_u32 s3, 262144
    s_cbranch_scc1 L_POLLDONE
    s_waitcnt vmcnt(0)
    v_cmp_ne_u32 vcc, 1, v12
    s_and_b64 vcc, vcc, s[90:91]
    s_cbranch_vccnz L_POLL
L_POLLDONE:
    buffer_load_dwordx4 v[96:99], v6, s[20:23], s70 offen offset:0 sc1
    buffer_load_dwordx4 v[100:103], v6, s[20:23], s70 offen offset:1024 sc1
    buffer_load_dwordx4 v[104:107], v6, s[20:23], s71 offen offset:0 sc1
    buffer_load_dwordx4 v[108:111], v6, s[20:23], s71 offen offset:1024 sc1
    buffer_load_dwordx4 v[112:115], v6, s[20:23], s72 offen offset:0 sc1
    buffer_load_dwordx4 v[116:119], v6, s[20:23], s72 offen offset:1024 sc1
    s_lshl_b32 s59, s62, 12
    s_add_u32 s62, s62, 1
    s_cmp_eq_u32 s62, 10
    s_cselect_b32 s62, 0, s62
    v_add_u32 v8, s59, v2
    v_add_u32 v9, s59, v3
    v_add_u32 v10, s59, v4
    v_add_u32 v11, s59, v5
    s_waitcnt vmcnt(4)
    v_mfma_f32_16x16x32_bf16 v[48:51], v[16:19], v[96:99], 0
    ds_read_b64_tr_b16 v[32:33], v8 offset:0
    ds_read_b64_tr_b16 v[34:35], v8 offset:512
    v_mfma_f32_16x16x32_bf16 v[64:67], v[16:19], v[100:103], 0
    v_mfma_f32_16x16x32_bf16 v[52:55], v[20:23], v[96:99], 0
    ds_read_b64_tr_b16 v[36:37], v9 offset:0
    ds_read_b64_tr_b16 v[38:39], v9 offset:512
    v_mfma_f32_16x16x32_bf16 v[68:71], v[20:23], v[100:103], 0
    buffer_load_dwordx4 v[120:123], v6, s[20:23], s73 offen offset:0 sc1
    buffer_load_dwordx4 v[124:127], v6, s[20:23], s73 offen offset:1024 sc1
    v_mfma_f32_16x16x32_bf16 v[56:59], v[24:27], v[96:99], 0
    ds_read_b64_tr_b16 v[40:41], v10 offset:0
    ds_read_b64_tr_b16 v[42:43], v10 offset:512
    v_mfma_f32_16x16x32_bf16 v[72:75], v[24:27], v[100:103], 0
    v_mfma_f32_16x16x32_bf16 v[60:63], v[28:31], v[96:99], 0
    ds_read_b64_tr_b16 v[44:45], v11 offset:0
    ds_read_b64_tr_b16 v[46:47], v11 offset:512
    v_mfma_f32_16x16x32_bf16 v[76:79], v[28:31], v[100:103], 0
    s_lshl_b32 s59, s62, 12
    s_add_u32 s62, s62, 1
    s_cmp_eq_u32 s62, 10
    s_cselect_b32 s62, 0, s62
    v_add_u32 v8, s59, v2
    v_add_u32 v9, s59, v3
    v_add_u32 v10, s59, v4
    v_add_u32 v11, s59, v5
    s_waitcnt vmcnt(4)
    s_waitcnt lgkmcnt(6)
    v_mfma_f32_16x16x32_bf16 v[48:51], v[32:35], v[104:107], v[48:51]
    ds_read_b64_tr_b16 v[16:17], v8 offset:0
    ds_read_b64_tr_b16 v[18:19], v8 offset:512
    v_mfma_f32_16x16x32_bf16 v[64:67], v[32:35], v[108:111], v[64:67]
    s_waitcnt lgkmcnt(6)
    v_mfma_f32_16x16x32_bf16 v[52:55], v[36:39], v[104:107], v[52:55]
    ds_read_b64_tr_b16 v[20:21], v9 offset:0
    ds_read_b64_tr_b16 v[22:23], v9 offset:512
    v_mfma_f32_16x16x32_bf16 v[68:71], v[36:39], v[108:111], v[68:71]
    buffer_load_dwordx4 v[128:131], v6, s[20:23], s74 offen offset:0 sc1
    buffer_load_dwordx4 v[132:135], v6, s[20:23], s74 offen offset:1024 sc1
    s_waitcnt lgkmcnt(6)
    v_mfma_f32_16x16x32_bf16 v[56:59], v[40:43], v[104:107], v[56:59]
    ds_read_b64_tr_b16 v[24:25], v10 offset:0
    ds_read_b64_tr_b16 v[26:27], v10 offset:512
    v_mfma_f32_16x16x32_bf16 v[72:75], v[40:43], v[108:111], v[72:75]
    s_waitcnt lgkmcnt(6)
    v_mfma_f32_16x16x32_bf16 v[60:63], v[44:47], v[104:107], v[60:63]
    ds_read_b64_tr_b16 v[28:29], v11 offset:0
    ds_read_b64_tr_b16 v[30:31], v11 offset:512
    v_mfma_f32_16x16x32_bf16 v[76:79], v[44:47], v[108:111], v[76:79]
    s_lshl_b32 s59, s62, 12
    s_add_u32 s62, s62, 1
    s_cmp_eq_u32 s62, 10
    s_cselect_b32 s62, 0, s62
    v_add_u32 v8, s59, v2
    v_add_u32 v9, s59, v3
    v_add_u32 v10, s59, v4
    v_add_u32 v11, s59, v5
    s_waitcnt vmcnt(4)
    s_waitcnt lgkmcnt(6)
    v_mfma_f32_16x16x32_bf16 v[48:51], v[16:19], v[112:115], v[48:51]
    ds_read_b64_tr_b16 v[32:33], v8 offset:0
    ds_read_b64_tr_b16 v[34:35], v8 offset:512
    v_mfma_f32_16x16x32_bf16 v[64:67], v[16:19], v[116:119], v[64:67]
    s_waitcnt lgkmcnt(6)
    v_mfma_f32_16x16x32_bf16 v[52:55], v[20:23], v[112:115], v[52:55]
    ds_read_b64_tr_b16 v[36:37], v9 offset:0
    ds_read_b64_tr_b16 v[38:39], v9 offset:512
    v_mfma_f32_16x16x32_bf16 v[68:71], v[20:23], v[116:119], v[68:71]
    buffer_load_dwordx4 v[136:139], v6, s[20:23], s75 offen offset:0 sc1
    buffer_load_dwordx4 v[140:143], v6, s[20:23], s75 offen offset:1024 sc1
    s_waitcnt lgkmcnt(6)
    v_mfma_f32_16x16x32_bf16 v[56:59], v[24:27], v[112:115], v[56:59]
    ds_read_b64_tr_b16 v[40:41], v10 offset:0
    ds_read_b64_tr_b16 v[42:43], v10 offset:512
    v_mfma_f32_16x16x32_bf16 v[72:75], v[24:27], v[116:119], v[72:75]
    s_waitcnt lgkmcnt(6)
    v_mfma_f32_16x16x32_bf16 v[60:63], v[28:31], v[112:115], v[60:63]
    ds_read_b64_tr_b16 v[44:45], v11 offset:0
    ds_read_b64_tr_b16 v[46:47], v11 offset:512
    v_mfma_f32_16x16x32_bf16 v[76:79], v[28:31], v[116:119], v[76:79]
    s_lshl_b32 s59, s62, 12
    s_add_u32 s62, s62, 1
    s_cmp_eq_u32 s62, 10
    s_cselect_b32 s62, 0, s62
    v_add_u32 v8, s59, v2
    v_add_u32 v9, s59, v3
    v_add_u32 v10, s59, v4
    v_add_u32 v11, s59, v5
    s_waitcnt vmcnt(4)
    s_waitcnt lgkmcnt(6)
    v_mfma_f32_16x16x32_bf16 v[48:51], v[32:35], v[120:123], v[48:51]
    ds_read_b64_tr_b16 v[16:17], v8 offset:0
    ds_read_b64_tr_b16 v[18:19], v8 offset:512
    v_mfma_f32_16x16x32_bf16 v[64:67], v[32:35], v[124:127], v[64:67]
    s_waitcnt lgkmcnt(6)
    v_mfma_f32_16x16x32_bf16 v[52:55], v[36:39], v[120:123], v[52:55]
    ds_read_b64_tr_b16 v[20:21], v9 offset:0
    ds_read_b64_tr_b16 v[22:23], v9 offset:512
    v_mfma_f32_16x16x32_bf16 v[68:71], v[36:39], v[124:127], v[68:71]
    buffer_load_dwordx4 v[144:147], v6, s[20:23], s76 offen offset:0 sc1
    buffer_load_dwordx4 v[148:151], v6, s[20:23], s76 offen offset:1024 sc1
    s_waitcnt lgkmcnt(6)
    v_mfma_f32_16x16x32_bf16 v[56:59], v[40:43], v[120:123], v[56:59]
    ds_read_b64_tr_b16 v[24:25], v10 offset:0
    ds_read_b64_tr_b16 v[26:27], v10 offset:512
    v_mfma_f32_16x16x32_bf16 v[72:75], v[40:43], v[124:127], v[72:75]
    s_waitcnt lgkmcnt(6)
    v_mfma_f32_16x16x32_bf16 v[60:63], v[44:47], v[120:123], v[60:63]
    ds_read_b64_tr_b16 v[28:29], v11 offset:0
    ds_read_b64_tr_b16 v[30:31], v11 offset:512
    v_mfma_f32_16x16x32_bf16 v[76:79], v[44:47], v[124:127], v[76:79]
    s_lshl_b32 s59, s62, 12
    s_add_u32 s62, s62, 1
    s_cmp_eq_u32 s62, 10
    s_cselect_b32 s62, 0, s62
    v_add_u32 v8, s59, v2
    v_add_u32 v9, s59, v3
    v_add_u32 v10, s59, v4
    v_add_u32 v11, s59, v5
    s_waitcnt vmcnt(4)
    s_waitcnt lgkmcnt(6)
    v_mfma_f32_16x16x32_bf16 v[48:51], v[16:19], v[128:131], v[48:51]
    ds_read_b64_tr_b16 v[32:33], v8 offset:0
    ds_read_b64_tr_b16 v[34:35], v8 offset:512
    v_mfma_f32_16x16x32_bf16 v[64:67], v[16:19], v[132:135], v[64:67]
    s_waitcnt lgkmcnt(6)
    v_mfma_f32_16x16x32_bf16 v[52:55], v[20:23], v[128:131], v[52:55]
    ds_read_b64_tr_b16 v[36:37], v9 offset:0
    ds_read_b64_tr_b16 v[38:39], v9 offset:512
    v_mfma_f32_16x16x32_bf16 v[68:71], v[20:23], v[132:135], v[68:71]
    buffer_load_dwordx4 v[152:155], v6, s[20:23], s77 offen offset:0 sc1
    buffer_load_dwordx4 v[156:159], v6, s[20:23], s77 offen offset:1024 sc1
    s_waitcnt lgkmcnt(6)
    v_mfma_f32_16x16x32_bf16 v[56:59], v[24:27], v[128:131], v[56:59]
    ds_read_b64_tr_b16 v[40:41], v10 offset:0
    ds_read_b64_tr_b16 v[42:43], v10 offset:512
    v_mfma_f32_16x16x32_bf16 v[72:75], v[24:27], v[132:135], v[72:75]
    s_waitcnt lgkmcnt(6)
    v_mfma_f32_16x16x32_bf16 v[60:63], v[28:31], v[128:131], v[60:63]
    ds_read_b64_tr_b16 v[44:45], v11 offset:0
    ds_read_b64_tr_b16 v[46:47], v11 offset:512
    v_mfma_f32_16x16x32_bf16 v[76:79], v[28:31], v[132:135], v[76:79]
    s_lshl_b32 s59, s62, 12
    s_add_u32 s62, s62, 1
    s_cmp_eq_u32 s62, 10
    s_cselect_b32 s62, 0, s62
    v_add_u32 v8, s59, v2
    v_add_u32 v9, s59, v3
    v_add_u32 v10, s59, v4
    v_add_u32 v11, s59, v5
    s_waitcnt vmcnt(4)
    s_waitcnt lgkmcnt(6)
    v_mfma_f32_16x16x32_bf16 v[48:51], v[32:35], v[136:139], v[48:51]
    ds_read_b64_tr_b16 v[16:17], v8 offset:0
    ds_read_b64_tr_b16 v[18:19], v8 offset:512
    v_mfma_f32_16x16x32_bf16 v[64:67], v[32:35], v[140:143], v[64:67]
    s_waitcnt lgkmcnt(6)
    v_mfma_f32_16x16x32_bf16 v[52:55], v[36:39], v[136:139], v[52:55]
    ds_read_b64_tr_b16 v[20:21], v9 offset:0
    ds_read_b64_tr_b16 v[22:23], v9 offset:512
    v_mfma_f32_16x16x32_bf16 v[68:71], v[36:39], v[140:143], v[68:71]
    buffer_load_dwordx4 v[160:163], v6, s[20:23], s78 offen offset:0 sc1
    buffer_load_dwordx4 v[164:167], v6, s[20:23], s78 offen offset:1024 sc1
    s_waitcnt lgkmcnt(6)
    v_mfma_f32_16x16x32_bf16 v[56:59], v[40:43], v[136:139], v[56:59]
    ds_read_b64_tr_b16 v[24:25], v10 offset:0
    ds_read_b64_tr_b16 v[26:27], v10 offset:512
    v_mfma_f32_16x16x32_bf16 v[72:75], v[40:43], v[140:143], v[72:75]
    s_waitcnt lgkmcnt(6)
    v_mfma_f32_16x16x32_bf16 v[60:63], v[44:47], v[136:139], v[60:63]
    ds_read_b64_tr_b16 v[28:29], v11 offset:0
    ds_read_b64_tr_b16 v[30:31], v11 offset:512
    v_mfma_f32_16x16x32_bf16 v[76:79], v[44:47], v[140:143], v[76:79]
    s_lshl_b32 s59, s62, 12
    s_add_u32 s62, s62, 1
    s_cmp_eq_u32 s62, 10
    s_cselect_b32 s62, 0, s62
    v_add_u32 v8, s59, v2
    v_add_u32 v9, s59, v3
    v_add_u32 v10, s59, v4
    v_add_u32 v11, s59, v5
    s_waitcnt vmcnt(4)
    s_waitcnt lgkmcnt(6)
    v_mfma_f32_16x16x32_bf16 v[48:51], v[16:19], v[144:147], v[48:51]
    ds_read_b64_tr_b16 v[32:33], v8 offset:0
    ds_read_b64_tr_b16 v[34:35], v8 offset:512
    v_mfma_f32_16x16x32_bf16 v[64:67], v[16:19], v[148:151], v[64:67]
    s_waitcnt lgkmcnt(6)
    v_mfma_f32_16x16x32_bf16 v[52:55], v[20:23], v[144:147], v[52:55]
    ds_read_b64_tr_b16 v[36:37], v9 offset:0
    ds_read_b64_tr_b16 v[38:39], v9 offset:512
    v_mfma_f32_16x16x32_bf16 v[68:71], v[20:23], v[148:151], v[68:71]
    buffer_load_dwordx4 v[168:171], v6, s[20:23], s79 offen offset:0 sc1
    buffer_load_dwordx4 v[172:175], v6, s[20:23], s79 offen offset:1024 sc1
    s_waitcnt lgkmcnt(6)
    v_mfma_f32_16x16x32_bf16 v[56:59], v[24:27], v[144:147], v[56:59]
    ds_read_b64_tr_b16 v[40:41], v10 offset:0
    ds_read_b64_tr_b16 v[42:43], v10 offset:512
    v_mfma_f32_16x16x32_bf16 v[72:75], v[24:27], v[148:151], v[72:75]
    s_waitcnt lgkmcnt(6)
    v_mfma_f32_16x16x32_bf16 v[60:63], v[28:31], v[144:147], v[60:63]
    ds_read_b64_tr_b16 v[44:45], v11 offset:0
    ds_read_b64_tr_b16 v[46:47], v11 offset:512
    v_mfma_f32_16x16x32_bf16 v[76:79], v[28:31], v[148:151], v[76:79]
    s_lshl_b32 s59, s62, 12
    s_add_u32 s62, s62, 1
    s_cmp_eq_u32 s62, 10
    s_cselect_b32 s62, 0, s62
    v_add_u32 v8, s59, v2
    v_add_u32 v9, s59, v3
    v_add_u32 v10, s59, v4
    v_add_u32 v11, s59, v5
    s_waitcnt vmcnt(4)
    s_waitcnt lgkmcnt(6)
    v_mfma_f32_16x16x32_bf16 v[48:51], v[32:35], v[152:155], v[48:51]
    ds_read_b64_tr_b16 v[16:17], v8 offset:0
    ds_read_b64_tr_b16 v[18:19], v8 offset:512
    v_mfma_f32_16x16x32_bf16 v[64:67], v[32:35], v[156:159], v[64:67]
    s_waitcnt lgkmcnt(6)
    v_mfma_f32_16x16x32_bf16 v[52:55], v[36:39], v[152:155], v[52:55]
    ds_read_b64_tr_b16 v[20:21], v9 offset:0
    ds_read_b64_tr_b16 v[22:23], v9 offset:512
    v_mfma_f32_16x16x32_bf16 v[68:71], v[36:39], v[156:159], v[68:71]
    buffer_load_dwordx4 v[176:179], v6, s[20:23], s80 offen offset:0 sc1
    buffer_load_dwordx4 v[180:183], v6, s[20:23], s80 offen offset:1024 sc1
    s_waitcnt lgkmcnt(6)
    v_mfma_f32_16x16x32_bf16 v[56:59], v[40:43], v[152:155], v[56:59]
    ds_read_b64_tr_b16 v[24:25], v10 offset:0
    ds_read_b64_tr_b16 v[26:27], v10 offset:512
    v_mfma_f32_16x16x32_bf16 v[72:75], v[40:43], v[156:159], v[72:75]
    s_waitcnt lgkmcnt(6)
    v_mfma_f32_16x16x32_bf16 v[60:63], v[44:47], v[152:155], v[60:63]
    ds_read_b64_tr_b16 v[28:29], v11 offset:0
    ds_read_b64_tr_b16 v[30:31], v11 offset:512
    v_mfma_f32_16x16x32_bf16 v[76:79], v[44:47], v[156:159], v[76:79]
    s_lshl_b32 s59, s62, 12
    s_add_u32 s62, s62, 1
    s_cmp_eq_u32 s62, 10
    s_cselect_b32 s62, 0, s62
    v_add_u32 v8, s59, v2
    v_add_u32 v9, s59, v3
    v_add_u32 v10, s59, v4
    v_add_u32 v11, s59, v5
    s_waitcnt vmcnt(4)
    s_waitcnt lgkmcnt(6)
    v_mfma_f32_16x16x32_bf16 v[48:51], v[16:19], v[160:163], v[48:51]
    ds_read_b64_tr_b16 v[32:33], v8 offset:0
    ds_read_b64_tr_b16 v[34:35], v8 offset:512
    v_mfma_f32_16x16x32_bf16 v[64:67], v[16:19], v[164:167], v[64:67]
    s_waitcnt lgkmcnt(6)
    v_mfma_f32_16x16x32_bf16 v[52:55], v[20:23], v[160:163], v[52:55]
    ds_read_b64_tr_b16 v[36:37], v9 offset:0
    ds_read_b64_tr_b16 v[38:39], v9 offset:512
    v_mfma_f32_16x16x32_bf16 v[68:71], v[20:23], v[164:167], v[68:71]
    s_waitcnt lgkmcnt(6)
    v_mfma_f32_16x16x32_bf16 v[56:59], v[24:27], v[160:163], v[56:59]
    ds_read_b64_tr_b16 v[40:41], v10 offset:0
    ds_read_b64_tr_b16 v[42:43], v10 offset:512
    v_mfma_f32_16x16x32_bf16 v[72:75], v[24:27], v[164:167], v[72:75]
    s_waitcnt lgkmcnt(6)
    v_mfma_f32_16x16x32_bf16 v[60:63], v[28:31], v[160:163], v[60:63]
    ds_read_b64_tr_b16 v[44:45], v11 offset:0
    ds_read_b64_tr_b16 v[46:47], v11 offset:512
    v_mfma_f32_16x16x32_bf16 v[76:79], v[28:31], v[164:167], v[76:79]
    v_add_u32 v8, s60, v2
    v_add_u32 v9, s60, v3
    v_add_u32 v10, s60, v4
    v_add_u32 v11, s60, v5
    s_waitcnt vmcnt(2)
    s_waitcnt lgkmcnt(6)
    v_mfma_f32_16x16x32_bf16 v[48:51], v[32:35], v[168:171], v[48:51]
    ds_read_b64_tr_b16 v[16:17], v8 offset:0
    ds_read_b64_tr_b16 v[18:19], v8 offset:512
    v_mfma_f32_16x16x32_bf16 v[64:67], v[32:35], v[172:175], v[64:67]
    s_waitcnt lgkmcnt(6)
    v_mfma_f32_16x16x32_bf16 v[52:55], v[36:39], v[168:171], v[52:55]
    ds_read_b64_tr_b16 v[20:21], v9 offset:0
    ds_read_b64_tr_b16 v[22:23], v9 offset:512
    v_mfma_f32_16x16x32_bf16 v[68:71], v[36:39], v[172:175], v[68:71]
    s_waitcnt lgkmcnt(6)
    v_mfma_f32_16x16x32_bf16 v[56:59], v[40:43], v[168:171], v[56:59]
    ds_read_b64_tr_b16 v[24:25], v10 offset:0
    ds_read_b64_tr_b16 v[26:27], v10 offset:512
    v_mfma_f32_16x16x32_bf16 v[72:75], v[40:43], v[172:175], v[72:75]
    s_waitcnt lgkmcnt(6)
    v_mfma_f32_16x16x32_bf16 v[60:63], v[44:47], v[168:171], v[60:63]
    ds_read_b64_tr_b16 v[28:29], v11 offset:0
    ds_read_b64_tr_b16 v[30:31], v11 offset:512
    v_mfma_f32_16x16x32_bf16 v[76:79], v[44:47], v[172:175], v[76:79]
    s_waitcnt vmcnt(0)
    s_waitcnt lgkmcnt(6)
    v_mfma_f32_16x16x32_bf16 v[48:51], v[16:19], v[176:179], v[48:51]
    v_mfma_f32_16x16x32_bf16 v[64:67], v[16:19], v[180:183], v[64:67]
    s_waitcnt lgkmcnt(4)
    v_mfma_f32_16x16x32_bf16 v[52:55], v[20:23], v[176:179], v[52:55]
    v_mfma_f32_16x16x32_bf16 v[68:71], v[20:23], v[180:183], v[68:71]
    s_waitcnt lgkmcnt(2)
    v_mfma_f32_16x16x32_bf16 v[56:59], v[24:27], v[176:179], v[56:59]
    v_mfma_f32_16x16x32_bf16 v[72:75], v[24:27], v[180:183], v[72:75]
    s_waitcnt lgkmcnt(0)
    v_mfma_f32_16x16x32_bf16 v[60:63], v[28:31], v[176:179], v[60:63]
    v_mfma_f32_16x16x32_bf16 v[76:79], v[28:31], v[180:183], v[76:79]
    s_barrier
    s_nop 7
    ds_write_b128 v15, v[48:51] offset:0
    ds_write_b128 v15, v[52:55] offset:1024
    ds_write_b128 v15, v[56:59] offset:2048
    ds_write_b128 v15, v[60:63] offset:3072
    ds_write_b128 v15, v[64:67] offset:4096
    ds_write_b128 v15, v[68:71] offset:5120
    ds_write_b128 v15, v[72:75] offset:6144
    ds_write_b128 v15, v[76:79] offset:7168
    s_lshl_b32 s58, s55, 12
    s_lshl_b32 s59, s63, 11
    s_add_u32 s58, s58, s59
    v_add_u32 v8, s58, v14
    v_add_u32 v9, 81920, v8
    s_lshl_b32 s58, s56, 6
    s_lshl_b32 s59, s55, 4
    s_add_u32 s58, s58, s59
    s_lshl_b32 s58, s58, 10
    s_lshl_b32 s59, s57, 7
    s_add_u32 s58, s58, s59
    s_lshl_b32 s59, s63, 6
    s_add_u32 s58, s58, s59
    v_and_b32 v10, 15, v1
    v_lshlrev_b32 v10, 10, v10
    v_bfe_u32 v11, v1, 4, 1
    v_lshl_add_u32 v10, v11, 5, v10
    v_lshrrev_b32 v11, 5, v1
    v_lshl_add_u32 v10, v11, 4, v10
    s_waitcnt lgkmcnt(0)
    s_barrier
    ds_read_b128 v[96:99], v8 offset:0
    ds_read_b128 v[100:103], v8 offset:1024
    ds_read_b128 v[104:107], v8 offset:40960
    ds_read_b128 v[108:111], v8 offset:41984
    ds_read_b128 v[112:115], v9 offset:0
    ds_read_b128 v[116:119], v9 offset:1024
    ds_read_b128 v[120:123], v9 offset:40960
    ds_read_b128 v[124:127], v9 offset:41984
    s_waitcnt lgkmcnt(4)
    v_pk_add_f32 v[96:97], v[96:97], v[104:105]
    v_pk_add_f32 v[98:99], v[98:99], v[106:107]
    v_pk_add_f32 v[100:101], v[100:101], v[108:109]
    v_pk_add_f32 v[102:103], v[102:103], v[110:111]
    s_waitcnt lgkmcnt(0)
    v_pk_add_f32 v[112:113], v[112:113], v[120:121]
    v_pk_add_f32 v[114:115], v[114:115], v[122:123]
    v_pk_add_f32 v[116:117], v[116:117], v[124:125]
    v_pk_add_f32 v[118:119], v[118:119], v[126:127]
    v_pk_add_f32 v[96:97], v[96:97], v[112:113]
    v_pk_add_f32 v[98:99], v[98:99], v[114:115]
    v_pk_add_f32 v[100:101], v[100:101], v[116:117]
    v_pk_add_f32 v[102:103], v[102:103], v[118:119]
    v_cvt_pk_bf16_f32 v16, v96, v97
    v_cvt_pk_bf16_f32 v17, v98, v99
    v_cvt_pk_bf16_f32 v18, v100, v101
    v_cvt_pk_bf16_f32 v19, v102, v103
    s_nop 1
    v_permlane16_swap_b32 v16, v18
    v_permlane16_swap_b32 v17, v19
    buffer_store_dwordx4 v[16:19], v10, s[28:31], s58 offen
L_END:
    s_endpgm
L_CNT:
    s_mov_b32 s97, 0
    v_mov_b32 v197, 1
    s_lshl_b32 s58, s50, 4
    s_waitcnt vmcnt(0)
    s_mov_b64 exec, 1
    buffer_store_dword v197, v13, s[32:35], s58 offen sc1
    s_mov_b64 exec, -1
    s_branch L_CNT_RET
L_CODE_END:
.section .rodata,"a"
.p2align 6
.amdhsa_kernel standalone__glu_gated_geglu__prompt_kernel
  .amdhsa_next_free_vgpr 256
  .amdhsa_next_free_sgpr 102
  .amdhsa_accum_offset 256
  .amdhsa_group_segment_fixed_size 0
  .amdhsa_kernarg_size 56
  .amdhsa_user_sgpr_count 2
  .amdhsa_user_sgpr_kernarg_segment_ptr 1
  .amdhsa_system_sgpr_workgroup_id_x 1
.end_amdhsa_kernel
```
